```python
import torch

def _softmax(x, axis=-1):
    return torch.softmax(x, dim=axis)
def _gelu(x):
    return torch.nn.functional.gelu(x, approximate="tanh")
def _silu(x):
    return torch.nn.functional.silu(x)
def _sigmoid(x):
    return torch.sigmoid(x)
def _layernorm(x, axis=-1, eps=1e-5):
    m = x.mean(dim=axis, keepdim=True)
    v = x.var(dim=axis, keepdim=True, unbiased=False)
    return (x - m) / torch.sqrt(v + eps)
def _scatter_add(tgt, idx, src, axis=0):
    return tgt.clone().index_add_(axis, idx, src)
def _segment_sum(src, seg, n):
    out = torch.zeros((n,) + src.shape[1:], dtype=src.dtype)
    return out.index_add_(0, seg, src)
def _pad(x, pw):
    flat = tuple(v for pair in reversed(pw) for v in pair)
    return torch.nn.functional.pad(x, flat)

kernel_name = 'parallel_sum__sliding_block_cached__geglu_ffn__decode'

def setup_inputs():

    _w = (lambda a: (lambda t: t.to(torch.bfloat16) if t.is_floating_point() else t)(torch.as_tensor(a)))
    def _A_setup():
        B, Sq, D = 2, 1, 640
        Hq, Hkv, Sk, Dh = 32, 32, 4096, 128
        assert Hq % Hkv == 0, (Hq, Hkv)
        return {
            "x": _w((lambda *s: torch.randn(*s, dtype=torch.bfloat16) * 0.05)(B, Sq, D)),
            "k_cache": _w((lambda *s: torch.randn(*s, dtype=torch.bfloat16) * 3.2)(B, Hkv, Sk, Dh)),
            "v_cache": _w((lambda *s: torch.randn(*s, dtype=torch.bfloat16) * 1.6)(B, Hkv, Sk, Dh)),
            "wq": _w((lambda *s: torch.randn(*s, dtype=torch.bfloat16) * 3.2)(D, Hq * Dh) * (D ** -0.5)),
            "wo": _w((lambda *s: torch.randn(*s, dtype=torch.bfloat16) * 1.6)(Hq * Dh, D) * ((Hq * Dh) ** -0.5)),
        }
    _A_in = _A_setup()

    def _B_setup():
        B, S, D, F = 2, 1, 640, 1728
        return {
            "x": _w((lambda *s: torch.randn(*s, dtype=torch.bfloat16) * 0.05)(B, S, D)),
            "w_gate": _w((lambda *s: torch.randn(*s, dtype=torch.bfloat16) * 0.05)(D, F)),
            "w_up": _w((lambda *s: torch.randn(*s, dtype=torch.bfloat16) * 0.05)(D, F)),
            "w_down": _w((lambda *s: torch.randn(*s, dtype=torch.bfloat16) * 0.05)(F, D)),
        }
    _B_in = _B_setup()

    return {
        "A_x": _A_in["x"],
        "A_k_cache": _A_in["k_cache"],
        "A_v_cache": _A_in["v_cache"],
        "A_wq": _A_in["wq"],
        "A_wo": _A_in["wo"],
        "B_x": _B_in["x"],
        "B_w_gate": _B_in["w_gate"],
        "B_w_up": _B_in["w_up"],
        "B_w_down": _B_in["w_down"],
    }

def reference(A_x, A_k_cache, A_v_cache, A_wq, A_wo, B_x, B_w_gate, B_w_up, B_w_down):
    def _A_ref(x, k_cache, v_cache, wq, wo):
        B, Sq, D = x.shape
        Hq, Dh = 32, 128
        Hkv, Sk = k_cache.shape[1], k_cache.shape[2]
        W = min(4096, max(256, Sk // 4))
        rep = Hq // Hkv
        q = (lambda x, *d: x.permute(*d))((x @ wq).reshape(B, Sq, Hq, Dh), 0, 2, 1, 3)
        k = (lambda x, n, axis: torch.repeat_interleave(x, n, dim=axis))(k_cache[:, :, Sk - W:, :], rep, axis=1)
        v = (lambda x, n, axis: torch.repeat_interleave(x, n, dim=axis))(v_cache[:, :, Sk - W:, :], rep, axis=1)
        scores = torch.einsum("bhqd,bhkd->bhqk", q, k) * (Dh ** -0.5)
        p = _softmax(scores, axis=-1)
        o = torch.einsum("bhqk,bhkd->bhqd", p, v)
        return (lambda x, *d: x.permute(*d))(o, 0, 2, 1, 3).reshape(B, Sq, Hq * Dh) @ wo

    def _B_ref(x, w_gate, w_up, w_down):
        return (_gelu(x @ w_gate) * (x @ w_up)) @ w_down

    x = A_x
    xn = _layernorm(x, axis=-1)
    return x + _A_ref(xn, A_k_cache, A_v_cache, A_wq, A_wo) + _B_ref(xn, B_w_gate, B_w_up, B_w_down)
```

```asm
; @launch grid=(256,1,1) block=(768,1,1) lds=15360
.amdgcn_target "amdgcn-amd-amdhsa--gfx950"
.text
.globl parallel_sum__sliding_block_cached__geglu_ffn__decode_kernel
.p2align 8
.type parallel_sum__sliding_block_cached__geglu_ffn__decode_kernel,@function
parallel_sum__sliding_block_cached__geglu_ffn__decode_kernel:
    v_lshrrev_b32 v1, 6, v0
    s_cmp_ge_u32 s2, 256
    v_readfirstlane_b32 s3, v1
    s_cbranch_scc1 L_end
    s_cmp_ge_u32 s3, 10
    s_cbranch_scc1 L_dry0
L_args:
    s_load_dwordx16 s[4:19], s[0:1], 0
    s_load_dwordx8 s[20:27], s[0:1], 64
    s_branch L_go
L_dry0:
    s_getpc_b64 s[58:59]
L_pc:
    v_lshlrev_b32 v1, 7, v0
    v_and_b32 v1, 0x3fff, v1
    v_cmp_gt_u32 vcc, (L_end - L_pc), v1
    v_mov_b32 v4, 0
    v_mov_b32 v5, 0
    s_mov_b64 exec, vcc
    global_load_dword v30, v1, s[58:59]
    s_mov_b64 exec, -1
    ds_write_b64 v4, v[4:5] offset:2880
    ds_write_b64 v4, v[4:5] offset:2888
    ds_write_b32 v4, v4 offset:2896
    s_waitcnt lgkmcnt(0)
    s_branch L_args
L_go:
    v_and_b32 v0, 63, v0
    s_and_b32 s28, s2, 7
    s_lshr_b32 s29, s2, 6
    s_lshl_b32 s29, s29, 3
    s_add_u32 s28, s28, s29
    s_bfe_u32 s29, s2, 0x30003
    s_barrier
    s_cmp_lg_u32 s3, 0
    s_cbranch_scc1 L_not0
    s_and_b32 s37, s29, 3
    s_lshr_b32 s39, s29, 2
    s_lshl_b32 s38, s28, 8
    s_lshl_b32 s40, s39, 7
    s_add_u32 s38, s38, s40
    s_mov_b32 s34, 8192
    s_lshl_b32 s35, s28, 13
    s_lshl_b32 s40, s37, 10
    s_add_u32 s35, s35, s40
    s_lshl_b32 s40, s39, 9
    s_add_u32 s35, s35, s40
    s_add_u32 s35, s35, 65536
    s_mov_b32 s36, 4096
    s_mov_b32 s40, 2
L_p1:
    v_lshrrev_b32 v1, 5, v0
    v_mul_u32_u24 v1, 1280, v1
    v_and_b32 v2, 31, v0
    v_lshl_add_u32 v1, v2, 3, v1
    v_lshrrev_b32 v2, 3, v0
    v_mul_u32_u24 v2, 20, v2
    v_and_b32 v3, 7, v0
    s_mul_i32 s39, s37, 160
    v_add_u32 v2, s39, v2
    v_mul_lo_u32 v2, v2, s34
    v_lshl_add_u32 v2, v3, 4, v2
    v_add_u32 v2, s38, v2
    s_cmp_eq_u32 s40, 0
    s_waitcnt lgkmcnt(0)
    s_cselect_b64 s[32:33], s[16:17], s[18:19]
    s_cmp_eq_u32 s40, 2
    s_cselect_b64 s[32:33], s[10:11], s[32:33]
    global_load_dwordx4 v[16:19], v2, s[32:33] nt
    v_add_u32 v2, s34, v2
    global_load_dwordx4 v[20:23], v2, s[32:33] nt
    v_add_u32 v2, s34, v2
    global_load_dwordx4 v[24:27], v2, s[32:33] nt
    v_add_u32 v2, s34, v2
    global_load_dwordx4 v[28:31], v2, s[32:33] nt
    v_add_u32 v2, s34, v2
    s_cbranch_scc0 L_nox
    global_load_dwordx2 v[96:97], v1, s[4:5] offset:0
    global_load_dwordx2 v[98:99], v1, s[4:5] offset:256
    global_load_dwordx2 v[100:101], v1, s[4:5] offset:512
    global_load_dwordx2 v[102:103], v1, s[4:5] offset:768
    global_load_dwordx2 v[104:105], v1, s[4:5] offset:1024
L_nox:
    global_load_dwordx4 v[32:35], v2, s[32:33] nt
    v_add_u32 v2, s34, v2
    global_load_dwordx4 v[36:39], v2, s[32:33] nt
    v_add_u32 v2, s34, v2
    global_load_dwordx4 v[40:43], v2, s[32:33] nt
    v_add_u32 v2, s34, v2
    global_load_dwordx4 v[44:47], v2, s[32:33] nt
    v_add_u32 v2, s34, v2
    global_load_dwordx4 v[48:51], v2, s[32:33] nt
    v_add_u32 v2, s34, v2
    global_load_dwordx4 v[52:55], v2, s[32:33] nt
    v_add_u32 v2, s34, v2
    global_load_dwordx4 v[56:59], v2, s[32:33] nt
    v_add_u32 v2, s34, v2
    global_load_dwordx4 v[60:63], v2, s[32:33] nt
    v_add_u32 v2, s34, v2
    global_load_dwordx4 v[64:67], v2, s[32:33] nt
    v_add_u32 v2, s34, v2
    global_load_dwordx4 v[68:71], v2, s[32:33] nt
    v_add_u32 v2, s34, v2
    global_load_dwordx4 v[72:75], v2, s[32:33] nt
    v_add_u32 v2, s34, v2
    global_load_dwordx4 v[76:79], v2, s[32:33] nt
    v_add_u32 v2, s34, v2
    global_load_dwordx4 v[80:83], v2, s[32:33] nt
    v_add_u32 v2, s34, v2
    global_load_dwordx4 v[84:87], v2, s[32:33] nt
    v_add_u32 v2, s34, v2
    global_load_dwordx4 v[88:91], v2, s[32:33] nt
    v_add_u32 v2, s34, v2
    global_load_dwordx4 v[92:95], v2, s[32:33] nt
    s_load_dword s30, s[26:27], 0
L_p1_dry:
    v_and_b32 v4, 1, v0
    v_lshlrev_b32 v4, 1, v4
    s_mov_b32 s56, 0x0c0c0100
    s_mov_b32 s57, 0x0c0c0302
    v_alignbyte_b32 v5, s56, s56, v4
    v_alignbyte_b32 v6, s57, s57, v4
    v_mov_b32 v4, 0x0c0c0c0c
    s_mov_b32 s56, 0x3030303
    s_mov_b32 s57, 0x3030303
    v_cndmask_b32 v8, v4, v5, s[56:57]
    v_cndmask_b32 v9, v4, v6, s[56:57]
    s_mov_b32 s56, 0xc0c0c0c
    s_mov_b32 s57, 0xc0c0c0c
    v_cndmask_b32 v10, v4, v5, s[56:57]
    v_cndmask_b32 v11, v4, v6, s[56:57]
    s_mov_b32 s56, 0x30303030
    s_mov_b32 s57, 0x30303030
    v_cndmask_b32 v12, v4, v5, s[56:57]
    v_cndmask_b32 v13, v4, v6, s[56:57]
    s_mov_b32 s56, 0xc0c0c0c0
    s_mov_b32 s57, 0xc0c0c0c0
    v_cndmask_b32 v14, v4, v5, s[56:57]
    v_cndmask_b32 v15, v4, v6, s[56:57]
    v_lshrrev_b32 v128, 5, v0
    v_mul_lo_u32 v128, v128, s36
    v_and_b32 v3, 7, v0
    v_lshl_add_u32 v128, v3, 6, v128
    v_bfe_u32 v3, v0, 4, 1
    v_lshl_add_u32 v128, v3, 5, v128
    v_bfe_u32 v3, v0, 3, 1
    v_lshl_add_u32 v128, v3, 4, v128
    v_add_u32 v128, s35, v128
    s_getreg_b32 s54, hwreg(HW_REG_XCC_ID, 0, 4)
    v_mov_b32 v132, 0
    v_mov_b32 v133, 0
    v_mov_b32 v134, 0
    v_mov_b32 v135, 0
    s_cbranch_execz L_pt_e
    s_cmp_eq_u32 s3, 0
    s_cbranch_scc1 L_pt_0
    global_load_ushort v129, v132, s[22:23]
    s_branch L_xw
L_pt_0:
    global_store_dwordx4 v128, v[132:135], s[26:27]
L_pt_e:
    s_waitcnt vmcnt(17)
    v_lshlrev_b32 v106, 16, v96
    v_and_b32 v107, 0xffff0000, v96
    v_lshlrev_b32 v108, 16, v97
    v_and_b32 v109, 0xffff0000, v97
    v_lshlrev_b32 v110, 16, v98
    v_and_b32 v111, 0xffff0000, v98
    v_lshlrev_b32 v112, 16, v99
    v_and_b32 v113, 0xffff0000, v99
    v_lshlrev_b32 v114, 16, v100
    v_and_b32 v115, 0xffff0000, v100
    v_lshlrev_b32 v116, 16, v101
    v_and_b32 v117, 0xffff0000, v101
    v_lshlrev_b32 v118, 16, v102
    v_and_b32 v119, 0xffff0000, v102
    v_lshlrev_b32 v120, 16, v103
    v_and_b32 v121, 0xffff0000, v103
    v_lshlrev_b32 v122, 16, v104
    v_and_b32 v123, 0xffff0000, v104
    v_lshlrev_b32 v124, 16, v105
    v_and_b32 v125, 0xffff0000, v105
    v_pk_add_f32 v[96:97], v[106:107], v[116:117]
    v_pk_add_f32 v[98:99], v[108:109], v[118:119]
    v_pk_add_f32 v[100:101], v[110:111], v[120:121]
    v_pk_add_f32 v[102:103], v[112:113], v[122:123]
    v_pk_add_f32 v[104:105], v[114:115], v[124:125]
    v_pk_add_f32 v[96:97], v[96:97], v[98:99]
    v_pk_add_f32 v[100:101], v[100:101], v[102:103]
    v_pk_add_f32 v[96:97], v[96:97], v[104:105]
    v_pk_add_f32 v[96:97], v[96:97], v[100:101]
    v_add_f32 v96, v96, v97
    s_nop 1
    v_add_f32 v96, v96, v96 row_ror:8
    s_nop 1
    v_add_f32 v96, v96, v96 row_ror:4
    s_nop 1
    v_add_f32 v96, v96, v96 row_ror:2
    s_nop 1
    v_add_f32 v96, v96, v96 row_ror:1
    v_mov_b32 v97, v96
    s_nop 1
    v_permlane16_swap_b32 v96, v97
    v_add_f32 v96, v96, v97
    v_mul_f32 v96, 0xbacccccd, v96
    v_mov_b32 v97, v96
    v_pk_add_f32 v[100:101], v[106:107], v[96:97]
    v_pk_mul_f32 v[98:99], v[100:101], v[100:101]
    v_pk_add_f32 v[102:103], v[108:109], v[96:97]
    v_pk_fma_f32 v[98:99], v[102:103], v[102:103], v[98:99]
    v_pk_add_f32 v[100:101], v[110:111], v[96:97]
    v_pk_fma_f32 v[98:99], v[100:101], v[100:101], v[98:99]
    v_pk_add_f32 v[102:103], v[112:113], v[96:97]
    v_pk_fma_f32 v[98:99], v[102:103], v[102:103], v[98:99]
    v_pk_add_f32 v[100:101], v[114:115], v[96:97]
    v_pk_fma_f32 v[98:99], v[100:101], v[100:101], v[98:99]
    v_pk_add_f32 v[102:103], v[116:117], v[96:97]
    v_pk_fma_f32 v[98:99], v[102:103], v[102:103], v[98:99]
    v_pk_add_f32 v[100:101], v[118:119], v[96:97]
    v_pk_fma_f32 v[98:99], v[100:101], v[100:101], v[98:99]
    v_pk_add_f32 v[102:103], v[120:121], v[96:97]
    v_pk_fma_f32 v[98:99], v[102:103], v[102:103], v[98:99]
    v_pk_add_f32 v[100:101], v[122:123], v[96:97]
    v_pk_fma_f32 v[98:99], v[100:101], v[100:101], v[98:99]
    v_pk_add_f32 v[102:103], v[124:125], v[96:97]
    v_pk_fma_f32 v[98:99], v[102:103], v[102:103], v[98:99]
    v_add_f32 v98, v98, v99
    s_nop 1
    v_add_f32 v98, v98, v98 row_ror:8
    s_nop 1
    v_add_f32 v98, v98, v98 row_ror:4
    s_nop 1
    v_add_f32 v98, v98, v98 row_ror:2
    s_nop 1
    v_add_f32 v98, v98, v98 row_ror:1
    v_mov_b32 v97, v98
    s_nop 1
    v_permlane16_swap_b32 v98, v97
    v_add_f32 v98, v98, v97
    v_mul_f32 v98, 0x3acccccd, v98
    v_cvt_pk_bf16_f32 v97, v96, v98
    v_lshlrev_b32 v126, 16, v97
    v_and_b32 v98, 0xffff0000, v97
    v_add_f32 v98, 0x3727c5ac, v98
    v_cvt_pk_bf16_f32 v98, v98, v98
    v_and_b32 v98, 0xffff0000, v98
    v_sqrt_f32 v98, v98
    v_mov_b32 v127, v126
    v_cvt_pk_bf16_f32 v98, v98, v98
    v_and_b32 v98, 0xffff0000, v98
    v_rcp_f32 v130, v98
    v_pk_add_f32 v[106:107], v[106:107], v[126:127]
    v_pk_add_f32 v[108:109], v[108:109], v[126:127]
    v_pk_add_f32 v[110:111], v[110:111], v[126:127]
    v_pk_add_f32 v[112:113], v[112:113], v[126:127]
    v_pk_add_f32 v[114:115], v[114:115], v[126:127]
    v_pk_add_f32 v[116:117], v[116:117], v[126:127]
    v_pk_add_f32 v[118:119], v[118:119], v[126:127]
    v_pk_add_f32 v[120:121], v[120:121], v[126:127]
    v_pk_add_f32 v[122:123], v[122:123], v[126:127]
    v_pk_add_f32 v[124:125], v[124:125], v[126:127]
    v_mov_b32 v131, v130
    v_cvt_pk_bf16_f32 v96, v106, v107
    v_cvt_pk_bf16_f32 v97, v108, v109
    v_cvt_pk_bf16_f32 v98, v110, v111
    v_cvt_pk_bf16_f32 v99, v112, v113
    v_cvt_pk_bf16_f32 v100, v114, v115
    v_cvt_pk_bf16_f32 v101, v116, v117
    v_cvt_pk_bf16_f32 v102, v118, v119
    v_cvt_pk_bf16_f32 v103, v120, v121
    v_cvt_pk_bf16_f32 v104, v122, v123
    v_cvt_pk_bf16_f32 v105, v124, v125
    v_lshlrev_b32 v106, 16, v96
    v_and_b32 v107, 0xffff0000, v96
    v_lshlrev_b32 v108, 16, v97
    v_and_b32 v109, 0xffff0000, v97
    v_lshlrev_b32 v110, 16, v98
    v_and_b32 v111, 0xffff0000, v98
    v_lshlrev_b32 v112, 16, v99
    v_and_b32 v113, 0xffff0000, v99
    v_lshlrev_b32 v114, 16, v100
    v_and_b32 v115, 0xffff0000, v100
    v_lshlrev_b32 v116, 16, v101
    v_and_b32 v117, 0xffff0000, v101
    v_lshlrev_b32 v118, 16, v102
    v_and_b32 v119, 0xffff0000, v102
    v_lshlrev_b32 v120, 16, v103
    v_and_b32 v121, 0xffff0000, v103
    v_lshlrev_b32 v122, 16, v104
    v_and_b32 v123, 0xffff0000, v104
    v_lshlrev_b32 v124, 16, v105
    v_and_b32 v125, 0xffff0000, v105
    v_pk_mul_f32 v[106:107], v[106:107], v[130:131]
    v_pk_mul_f32 v[108:109], v[108:109], v[130:131]
    v_pk_mul_f32 v[110:111], v[110:111], v[130:131]
    v_pk_mul_f32 v[112:113], v[112:113], v[130:131]
    v_pk_mul_f32 v[114:115], v[114:115], v[130:131]
    v_pk_mul_f32 v[116:117], v[116:117], v[130:131]
    v_pk_mul_f32 v[118:119], v[118:119], v[130:131]
    v_pk_mul_f32 v[120:121], v[120:121], v[130:131]
    v_pk_mul_f32 v[122:123], v[122:123], v[130:131]
    v_pk_mul_f32 v[124:125], v[124:125], v[130:131]
    v_cvt_pk_bf16_f32 v96, v106, v107
    v_cvt_pk_bf16_f32 v97, v108, v109
    v_cvt_pk_bf16_f32 v98, v110, v111
    v_cvt_pk_bf16_f32 v99, v112, v113
    v_cvt_pk_bf16_f32 v100, v114, v115
    v_cvt_pk_bf16_f32 v101, v116, v117
    v_cvt_pk_bf16_f32 v102, v118, v119
    v_cvt_pk_bf16_f32 v103, v120, v121
    v_cvt_pk_bf16_f32 v104, v122, v123
    v_cvt_pk_bf16_f32 v105, v124, v125
    ds_write_b64 v1, v[96:97] offset:0
    ds_write_b64 v1, v[98:99] offset:256
    ds_write_b64 v1, v[100:101] offset:512
    ds_write_b64 v1, v[102:103] offset:768
    ds_write_b64 v1, v[104:105] offset:1024
    v_mov_b32 v3, 1
    ds_write_b32 v132, v3 offset:2896
    s_branch L_xr
L_xw:
    s_sleep 1
    ds_read_b32 v3, v132 offset:2896
    s_waitcnt lgkmcnt(0)
    v_cmp_eq_u32 vcc, 0, v3
    s_cbranch_vccnz L_xw
L_xr:
    v_bfe_u32 v2, v0, 3, 1
    v_mul_u32_u24 v2, 1280, v2
    v_lshrrev_b32 v3, 4, v0
    v_mul_u32_u24 v3, 80, v3
    s_mul_i32 s39, s37, 320
    v_add3_u32 v2, v2, v3, s39
    s_waitcnt lgkmcnt(0)
    ds_read_b128 v[96:99], v2 offset:0
    ds_read_b128 v[100:103], v2 offset:16
    ds_read_b128 v[104:107], v2 offset:32
    ds_read_b128 v[108:111], v2 offset:48
    ds_read_b128 v[112:115], v2 offset:64
    s_mul_i32 s30, s30, 0x9E3779B1
    s_add_u32 s30, s30, 0x7F4A7C15
    s_xor_b32 s55, s30, s54
    s_cmp_eq_u32 s3, 0
    s_cselect_b32 s55, s55, s30
    v_mov_b32 v133, s55
    v_mov_b32 v135, s55
    s_waitcnt lgkmcnt(0)
    v_perm_b32 v116, v96, v96, v8
    v_perm_b32 v117, v96, v96, v10
    v_perm_b32 v118, v96, v96, v12
    v_perm_b32 v119, v96, v96, v14
    v_perm_b32 v120, v106, v106, v8
    v_perm_b32 v121, v106, v106, v10
    v_perm_b32 v122, v106, v106, v12
    v_perm_b32 v123, v106, v106, v14
    s_waitcnt vmcnt(20)
    v_mfma_f32_16x16x32_bf16 v[124:127], v[116:119], v[16:19], 0
    v_mfma_f32_16x16x32_bf16 v[4:7], v[120:123], v[16:19], 0
    v_perm_b32 v116, v96, v96, v9
    v_perm_b32 v117, v96, v96, v11
    v_perm_b32 v118, v96, v96, v13
    v_perm_b32 v119, v96, v96, v15
    v_perm_b32 v120, v106, v106, v9
    v_perm_b32 v121, v106, v106, v11
    v_perm_b32 v122, v106, v106, v13
    v_perm_b32 v123, v106, v106, v15
    s_waitcnt vmcnt(19)
    v_mfma_f32_16x16x32_bf16 v[124:127], v[116:119], v[20:23], v[124:127]
    v_mfma_f32_16x16x32_bf16 v[4:7], v[120:123], v[20:23], v[4:7]
    v_perm_b32 v116, v97, v97, v8
    v_perm_b32 v117, v97, v97, v10
    v_perm_b32 v118, v97, v97, v12
    v_perm_b32 v119, v97, v97, v14
    v_perm_b32 v120, v107, v107, v8
    v_perm_b32 v121, v107, v107, v10
    v_perm_b32 v122, v107, v107, v12
    v_perm_b32 v123, v107, v107, v14
    s_waitcnt vmcnt(18)
    v_mfma_f32_16x16x32_bf16 v[124:127], v[116:119], v[24:27], v[124:127]
    v_mfma_f32_16x16x32_bf16 v[4:7], v[120:123], v[24:27], v[4:7]
    v_perm_b32 v116, v97, v97, v9
    v_perm_b32 v117, v97, v97, v11
    v_perm_b32 v118, v97, v97, v13
    v_perm_b32 v119, v97, v97, v15
    v_perm_b32 v120, v107, v107, v9
    v_perm_b32 v121, v107, v107, v11
    v_perm_b32 v122, v107, v107, v13
    v_perm_b32 v123, v107, v107, v15
    s_waitcnt vmcnt(17)
    v_mfma_f32_16x16x32_bf16 v[124:127], v[116:119], v[28:31], v[124:127]
    v_mfma_f32_16x16x32_bf16 v[4:7], v[120:123], v[28:31], v[4:7]
    v_perm_b32 v116, v98, v98, v8
    v_perm_b32 v117, v98, v98, v10
    v_perm_b32 v118, v98, v98, v12
    v_perm_b32 v119, v98, v98, v14
    v_perm_b32 v120, v108, v108, v8
    v_perm_b32 v121, v108, v108, v10
    v_perm_b32 v122, v108, v108, v12
    v_perm_b32 v123, v108, v108, v14
    s_waitcnt vmcnt(16)
    v_mfma_f32_16x16x32_bf16 v[124:127], v[116:119], v[32:35], v[124:127]
    v_mfma_f32_16x16x32_bf16 v[4:7], v[120:123], v[32:35], v[4:7]
    v_perm_b32 v116, v98, v98, v9
    v_perm_b32 v117, v98, v98, v11
    v_perm_b32 v118, v98, v98, v13
    v_perm_b32 v119, v98, v98, v15
    v_perm_b32 v120, v108, v108, v9
    v_perm_b32 v121, v108, v108, v11
    v_perm_b32 v122, v108, v108, v13
    v_perm_b32 v123, v108, v108, v15
    s_waitcnt vmcnt(15)
    v_mfma_f32_16x16x32_bf16 v[124:127], v[116:119], v[36:39], v[124:127]
    v_mfma_f32_16x16x32_bf16 v[4:7], v[120:123], v[36:39], v[4:7]
    v_perm_b32 v116, v99, v99, v8
    v_perm_b32 v117, v99, v99, v10
    v_perm_b32 v118, v99, v99, v12
    v_perm_b32 v119, v99, v99, v14
    v_perm_b32 v120, v109, v109, v8
    v_perm_b32 v121, v109, v109, v10
    v_perm_b32 v122, v109, v109, v12
    v_perm_b32 v123, v109, v109, v14
    s_waitcnt vmcnt(14)
    v_mfma_f32_16x16x32_bf16 v[124:127], v[116:119], v[40:43], v[124:127]
    v_mfma_f32_16x16x32_bf16 v[4:7], v[120:123], v[40:43], v[4:7]
    v_perm_b32 v116, v99, v99, v9
    v_perm_b32 v117, v99, v99, v11
    v_perm_b32 v118, v99, v99, v13
    v_perm_b32 v119, v99, v99, v15
    v_perm_b32 v120, v109, v109, v9
    v_perm_b32 v121, v109, v109, v11
    v_perm_b32 v122, v109, v109, v13
    v_perm_b32 v123, v109, v109, v15
    s_waitcnt vmcnt(13)
    v_mfma_f32_16x16x32_bf16 v[124:127], v[116:119], v[44:47], v[124:127]
    v_mfma_f32_16x16x32_bf16 v[4:7], v[120:123], v[44:47], v[4:7]
    v_perm_b32 v116, v100, v100, v8
    v_perm_b32 v117, v100, v100, v10
    v_perm_b32 v118, v100, v100, v12
    v_perm_b32 v119, v100, v100, v14
    v_perm_b32 v120, v110, v110, v8
    v_perm_b32 v121, v110, v110, v10
    v_perm_b32 v122, v110, v110, v12
    v_perm_b32 v123, v110, v110, v14
    s_waitcnt vmcnt(12)
    v_mfma_f32_16x16x32_bf16 v[124:127], v[116:119], v[48:51], v[124:127]
    v_mfma_f32_16x16x32_bf16 v[4:7], v[120:123], v[48:51], v[4:7]
    v_perm_b32 v116, v100, v100, v9
    v_perm_b32 v117, v100, v100, v11
    v_perm_b32 v118, v100, v100, v13
    v_perm_b32 v119, v100, v100, v15
    v_perm_b32 v120, v110, v110, v9
    v_perm_b32 v121, v110, v110, v11
    v_perm_b32 v122, v110, v110, v13
    v_perm_b32 v123, v110, v110, v15
    s_waitcnt vmcnt(11)
    v_mfma_f32_16x16x32_bf16 v[124:127], v[116:119], v[52:55], v[124:127]
    v_mfma_f32_16x16x32_bf16 v[4:7], v[120:123], v[52:55], v[4:7]
    v_perm_b32 v116, v101, v101, v8
    v_perm_b32 v117, v101, v101, v10
    v_perm_b32 v118, v101, v101, v12
    v_perm_b32 v119, v101, v101, v14
    v_perm_b32 v120, v111, v111, v8
    v_perm_b32 v121, v111, v111, v10
    v_perm_b32 v122, v111, v111, v12
    v_perm_b32 v123, v111, v111, v14
    s_waitcnt vmcnt(10)
    v_mfma_f32_16x16x32_bf16 v[124:127], v[116:119], v[56:59], v[124:127]
    v_mfma_f32_16x16x32_bf16 v[4:7], v[120:123], v[56:59], v[4:7]
    v_perm_b32 v116, v101, v101, v9
    v_perm_b32 v117, v101, v101, v11
    v_perm_b32 v118, v101, v101, v13
    v_perm_b32 v119, v101, v101, v15
    v_perm_b32 v120, v111, v111, v9
    v_perm_b32 v121, v111, v111, v11
    v_perm_b32 v122, v111, v111, v13
    v_perm_b32 v123, v111, v111, v15
    s_waitcnt vmcnt(9)
    v_mfma_f32_16x16x32_bf16 v[124:127], v[116:119], v[60:63], v[124:127]
    v_mfma_f32_16x16x32_bf16 v[4:7], v[120:123], v[60:63], v[4:7]
    v_perm_b32 v116, v102, v102, v8
    v_perm_b32 v117, v102, v102, v10
    v_perm_b32 v118, v102, v102, v12
    v_perm_b32 v119, v102, v102, v14
    v_perm_b32 v120, v112, v112, v8
    v_perm_b32 v121, v112, v112, v10
    v_perm_b32 v122, v112, v112, v12
    v_perm_b32 v123, v112, v112, v14
    s_waitcnt vmcnt(8)
    v_mfma_f32_16x16x32_bf16 v[124:127], v[116:119], v[64:67], v[124:127]
    v_mfma_f32_16x16x32_bf16 v[4:7], v[120:123], v[64:67], v[4:7]
    v_perm_b32 v116, v102, v102, v9
    v_perm_b32 v117, v102, v102, v11
    v_perm_b32 v118, v102, v102, v13
    v_perm_b32 v119, v102, v102, v15
    v_perm_b32 v120, v112, v112, v9
    v_perm_b32 v121, v112, v112, v11
    v_perm_b32 v122, v112, v112, v13
    v_perm_b32 v123, v112, v112, v15
    s_waitcnt vmcnt(7)
    v_mfma_f32_16x16x32_bf16 v[124:127], v[116:119], v[68:71], v[124:127]
    v_mfma_f32_16x16x32_bf16 v[4:7], v[120:123], v[68:71], v[4:7]
    v_perm_b32 v116, v103, v103, v8
    v_perm_b32 v117, v103, v103, v10
    v_perm_b32 v118, v103, v103, v12
    v_perm_b32 v119, v103, v103, v14
    v_perm_b32 v120, v113, v113, v8
    v_perm_b32 v121, v113, v113, v10
    v_perm_b32 v122, v113, v113, v12
    v_perm_b32 v123, v113, v113, v14
    s_waitcnt vmcnt(6)
    v_mfma_f32_16x16x32_bf16 v[124:127], v[116:119], v[72:75], v[124:127]
    v_mfma_f32_16x16x32_bf16 v[4:7], v[120:123], v[72:75], v[4:7]
    v_perm_b32 v116, v103, v103, v9
    v_perm_b32 v117, v103, v103, v11
    v_perm_b32 v118, v103, v103, v13
    v_perm_b32 v119, v103, v103, v15
    v_perm_b32 v120, v113, v113, v9
    v_perm_b32 v121, v113, v113, v11
    v_perm_b32 v122, v113, v113, v13
    v_perm_b32 v123, v113, v113, v15
    s_waitcnt vmcnt(5)
    v_mfma_f32_16x16x32_bf16 v[124:127], v[116:119], v[76:79], v[124:127]
    v_mfma_f32_16x16x32_bf16 v[4:7], v[120:123], v[76:79], v[4:7]
    v_perm_b32 v116, v104, v104, v8
    v_perm_b32 v117, v104, v104, v10
    v_perm_b32 v118, v104, v104, v12
    v_perm_b32 v119, v104, v104, v14
    v_perm_b32 v120, v114, v114, v8
    v_perm_b32 v121, v114, v114, v10
    v_perm_b32 v122, v114, v114, v12
    v_perm_b32 v123, v114, v114, v14
    s_waitcnt vmcnt(4)
    v_mfma_f32_16x16x32_bf16 v[124:127], v[116:119], v[80:83], v[124:127]
    v_mfma_f32_16x16x32_bf16 v[4:7], v[120:123], v[80:83], v[4:7]
    v_perm_b32 v116, v104, v104, v9
    v_perm_b32 v117, v104, v104, v11
    v_perm_b32 v118, v104, v104, v13
    v_perm_b32 v119, v104, v104, v15
    v_perm_b32 v120, v114, v114, v9
    v_perm_b32 v121, v114, v114, v11
    v_perm_b32 v122, v114, v114, v13
    v_perm_b32 v123, v114, v114, v15
    s_waitcnt vmcnt(3)
    v_mfma_f32_16x16x32_bf16 v[124:127], v[116:119], v[84:87], v[124:127]
    v_mfma_f32_16x16x32_bf16 v[4:7], v[120:123], v[84:87], v[4:7]
    v_perm_b32 v116, v105, v105, v8
    v_perm_b32 v117, v105, v105, v10
    v_perm_b32 v118, v105, v105, v12
    v_perm_b32 v119, v105, v105, v14
    v_perm_b32 v120, v115, v115, v8
    v_perm_b32 v121, v115, v115, v10
    v_perm_b32 v122, v115, v115, v12
    v_perm_b32 v123, v115, v115, v14
    s_waitcnt vmcnt(2)
    v_mfma_f32_16x16x32_bf16 v[124:127], v[116:119], v[88:91], v[124:127]
    v_mfma_f32_16x16x32_bf16 v[4:7], v[120:123], v[88:91], v[4:7]
    v_perm_b32 v116, v105, v105, v9
    v_perm_b32 v117, v105, v105, v11
    v_perm_b32 v118, v105, v105, v13
    v_perm_b32 v119, v105, v105, v15
    v_perm_b32 v120, v115, v115, v9
    v_perm_b32 v121, v115, v115, v11
    v_perm_b32 v122, v115, v115, v13
    v_perm_b32 v123, v115, v115, v15
    s_waitcnt vmcnt(1)
    v_mfma_f32_16x16x32_bf16 v[124:127], v[116:119], v[92:95], v[124:127]
    v_mfma_f32_16x16x32_bf16 v[4:7], v[120:123], v[92:95], v[4:7]
    s_nop 7
    v_add_f32 v132, v4, v124 row_ror:8 bank_mask:0x3
    v_add_f32 v134, v5, v125 row_ror:8 bank_mask:0x3
    s_nop 0
    v_add_f32 v132, v126, v6 row_ror:8 bank_mask:0xc
    v_add_f32 v134, v127, v7 row_ror:8 bank_mask:0xc
    s_cmp_lg_u32 s3, 1
    s_cbranch_scc1 L_w0
    s_cbranch_execz L_w0
    global_store_dwordx4 v128, v[132:135], s[26:27] sc1
    s_branch L_exit
L_w0:
    s_cbranch_execz L_sk_1
    global_store_dwordx4 v128, v[132:135], s[26:27]
L_sk_1:
    s_lshr_b32 s39, s29, 2
    s_lshl_b32 s40, s28, 1
    s_add_u32 s39, s39, s40
    s_lshl_b32 s39, s39, 12
    s_add_u32 s39, s39, 65536
    v_lshl_add_u32 v2, v0, 4, s39
    s_lshl_b32 s39, s28, 3
    s_add_u32 s39, s39, s29
    s_mul_i32 s39, s39, 1152
    s_add_u32 s39, s39, 655360
    v_lshl_add_u32 v1, v0, 4, s39
    v_mov_b32 v4, 0
    s_mov_b32 s41, 0
    s_cbranch_execz L_sk_2
    s_sleep 4
    global_load_dwordx4 v[24:27], v2, s[26:27] offset:0 sc1
    global_load_dwordx4 v[28:31], v2, s[26:27] offset:1024 sc1
    global_load_dwordx4 v[32:35], v2, s[26:27] offset:2048 sc1
    global_load_dwordx4 v[36:39], v2, s[26:27] offset:3072 sc1
    s_sleep 10
    global_load_dwordx4 v[40:43], v2, s[26:27] offset:0 sc1
    global_load_dwordx4 v[44:47], v2, s[26:27] offset:1024 sc1
    global_load_dwordx4 v[48:51], v2, s[26:27] offset:2048 sc1
    global_load_dwordx4 v[52:55], v2, s[26:27] offset:3072 sc1
    s_sleep 10
    global_load_dwordx4 v[56:59], v2, s[26:27] offset:0 sc1
    global_load_dwordx4 v[60:63], v2, s[26:27] offset:1024 sc1
    global_load_dwordx4 v[64:67], v2, s[26:27] offset:2048 sc1
    global_load_dwordx4 v[68:71], v2, s[26:27] offset:3072 sc1
    s_sleep 10
L_sk_2:
L_pollA:
    s_cbranch_execz L_sk_3
    global_load_dwordx4 v[72:75], v2, s[26:27] offset:0 sc1
    global_load_dwordx4 v[76:79], v2, s[26:27] offset:1024 sc1
    global_load_dwordx4 v[80:83], v2, s[26:27] offset:2048 sc1
    global_load_dwordx4 v[84:87], v2, s[26:27] offset:3072 sc1
L_sk_3:
    s_waitcnt vmcnt(12)
    v_xor_b32 v16, s55, v25
    v_xor_b32 v17, s55, v27
    v_xor_b32 v18, s55, v29
    v_xor_b32 v19, s55, v31
    v_xor_b32 v20, s55, v33
    v_xor_b32 v21, s55, v35
    v_xor_b32 v22, s55, v37
    v_xor_b32 v23, s55, v39
    v_or3_b32 v16, v16, v17, v18
    v_or3_b32 v19, v19, v20, v21
    v_or3_b32 v16, v16, v22, v23
    v_or_b32 v16, v16, v19
    v_add_f32 v18, v24, v28
    v_add_f32 v19, v32, v36
    v_add_f32 v20, v26, v30
    v_add_f32 v21, v34, v38
    v_cmp_lt_u32 vcc, 15, v16
    s_add_u32 s41, s41, 1
    s_cbranch_execz L_pa_n0
    s_cbranch_vccz L_pollA_done
L_pa_n0:
    s_cbranch_execz L_sk_4
    global_load_dwordx4 v[24:27], v2, s[26:27] offset:0 sc1
    global_load_dwordx4 v[28:31], v2, s[26:27] offset:1024 sc1
    global_load_dwordx4 v[32:35], v2, s[26:27] offset:2048 sc1
    global_load_dwordx4 v[36:39], v2, s[26:27] offset:3072 sc1
L_sk_4:
    s_waitcnt vmcnt(12)
    v_xor_b32 v16, s55, v41
    v_xor_b32 v17, s55, v43
    v_xor_b32 v18, s55, v45
    v_xor_b32 v19, s55, v47
    v_xor_b32 v20, s55, v49
    v_xor_b32 v21, s55, v51
    v_xor_b32 v22, s55, v53
    v_xor_b32 v23, s55, v55
    v_or3_b32 v16, v16, v17, v18
    v_or3_b32 v19, v19, v20, v21
    v_or3_b32 v16, v16, v22, v23
    v_or_b32 v16, v16, v19
    v_add_f32 v18, v40, v44
    v_add_f32 v19, v48, v52
    v_add_f32 v20, v42, v46
    v_add_f32 v21, v50, v54
    v_cmp_lt_u32 vcc, 15, v16
    s_add_u32 s41, s41, 1
    s_cbranch_execz L_pa_n1
    s_cbranch_vccz L_pollA_done
L_pa_n1:
    s_cbranch_execz L_sk_5
    global_load_dwordx4 v[40:43], v2, s[26:27] offset:0 sc1
    global_load_dwordx4 v[44:47], v2, s[26:27] offset:1024 sc1
    global_load_dwordx4 v[48:51], v2, s[26:27] offset:2048 sc1
    global_load_dwordx4 v[52:55], v2, s[26:27] offset:3072 sc1
L_sk_5:
    s_waitcnt vmcnt(12)
    v_xor_b32 v16, s55, v57
    v_xor_b32 v17, s55, v59
    v_xor_b32 v18, s55, v61
    v_xor_b32 v19, s55, v63
    v_xor_b32 v20, s55, v65
    v_xor_b32 v21, s55, v67
    v_xor_b32 v22, s55, v69
    v_xor_b32 v23, s55, v71
    v_or3_b32 v16, v16, v17, v18
    v_or3_b32 v19, v19, v20, v21
    v_or3_b32 v16, v16, v22, v23
    v_or_b32 v16, v16, v19
    v_add_f32 v18, v56, v60
    v_add_f32 v19, v64, v68
    v_add_f32 v20, v58, v62
    v_add_f32 v21, v66, v70
    v_cmp_lt_u32 vcc, 15, v16
    s_add_u32 s41, s41, 1
    s_cbranch_execz L_pa_n2
    s_cbranch_vccz L_pollA_done
L_pa_n2:
    s_cbranch_execz L_sk_6
    global_load_dwordx4 v[56:59], v2, s[26:27] offset:0 sc1
    global_load_dwordx4 v[60:63], v2, s[26:27] offset:1024 sc1
    global_load_dwordx4 v[64:67], v2, s[26:27] offset:2048 sc1
    global_load_dwordx4 v[68:71], v2, s[26:27] offset:3072 sc1
L_sk_6:
    s_waitcnt vmcnt(12)
    v_xor_b32 v16, s55, v73
    v_xor_b32 v17, s55, v75
    v_xor_b32 v18, s55, v77
    v_xor_b32 v19, s55, v79
    v_xor_b32 v20, s55, v81
    v_xor_b32 v21, s55, v83
    v_xor_b32 v22, s55, v85
    v_xor_b32 v23, s55, v87
    v_or3_b32 v16, v16, v17, v18
    v_or3_b32 v19, v19, v20, v21
    v_or3_b32 v16, v16, v22, v23
    v_or_b32 v16, v16, v19
    v_add_f32 v18, v72, v76
    v_add_f32 v19, v80, v84
    v_add_f32 v20, v74, v78
    v_add_f32 v21, v82, v86
    v_cmp_lt_u32 vcc, 15, v16
    s_add_u32 s41, s41, 1
    s_cbranch_vccz L_pollA_done
    s_cmp_lg_u32 s41, 16
    s_cbranch_scc1 L_pollA_w
    global_store_dwordx4 v128, v[132:135], s[26:27] sc1
    s_waitcnt vmcnt(0)
L_pollA_w:
    s_cmp_lt_u32 s41, 400000
    s_cbranch_scc1 L_pollA
L_pollA_done:
    v_add_f32 v18, v18, v19
    v_add_f32 v20, v20, v21
    v_cvt_pk_bf16_f32 v18, v18, v20
    v_lshlrev_b32 v3, 2, v0
    ds_write_b32 v3, v18 offset:2560
    v_mov_b32 v5, 1
    ds_write_b32 v4, v5 offset:2880
    v_cmp_ne_u32 s[60:61], 0, v16
    v_lshlrev_b32 v3, 3, v0
    v_mov_b32 v96, 0
    v_mov_b32 v97, 0
    v_mov_b32 v98, 0
    v_mov_b32 v99, 0
    v_mov_b32 v121, s30
    v_mov_b32 v123, s30
    v_mov_b32 v117, s30
    v_mov_b32 v119, s30
    s_mov_b32 s42, 0x3fb8aa3b
    s_cbranch_execz L_w0_st
    s_cmp_eq_u64 s[60:61], 0
    s_cbranch_scc1 L_w0_local
    global_store_dwordx4 v128, v[132:135], s[26:27] sc1
    s_branch L_w0_spin
L_w0_local:
    global_store_dwordx4 v1, v[96:99], s[26:27]
    s_mov_b64 exec, 0xff
    global_store_dwordx4 v1, v[96:99], s[26:27] offset:1024
    s_mov_b64 exec, -1
L_w0_spin:
    s_sleep 1
    ds_read_b32 v5, v4 offset:2884
    s_waitcnt lgkmcnt(0)
    v_cmp_ne_u32 vcc, 8, v5
    s_cbranch_vccnz L_w0_spin
L_w0_st:
    ds_read_b128 v[100:103], v4 offset:2816
    ds_read_b128 v[104:107], v4 offset:2832
    ds_read_b128 v[108:111], v4 offset:2848
    ds_read_b128 v[112:115], v4 offset:2864
    s_waitcnt lgkmcnt(0)
    v_max3_f32 v116, v100, v102, v104
    v_max3_f32 v5, v106, v108, v110
    v_max3_f32 v116, v116, v112, v114
    v_max_f32 v116, v116, v5
    v_sub_f32 v8, v100, v116
    v_sub_f32 v10, v102, v116
    v_sub_f32 v12, v104, v116
    v_sub_f32 v14, v106, v116
    v_sub_f32 v16, v108, v116
    v_sub_f32 v18, v110, v116
    v_sub_f32 v20, v112, v116
    v_sub_f32 v22, v114, v116
    v_mul_f32 v8, s42, v8
    v_mul_f32 v10, s42, v10
    v_mul_f32 v12, s42, v12
    v_mul_f32 v14, s42, v14
    v_mul_f32 v16, s42, v16
    v_mul_f32 v18, s42, v18
    v_mul_f32 v20, s42, v20
    v_mul_f32 v22, s42, v22
    v_exp_f32 v8, v8
    v_exp_f32 v10, v10
    v_exp_f32 v12, v12
    v_exp_f32 v14, v14
    v_exp_f32 v16, v16
    v_exp_f32 v18, v18
    v_exp_f32 v20, v20
    v_exp_f32 v22, v22
    v_mul_f32 v118, v8, v101
    v_fmac_f32 v118, v10, v103
    v_fmac_f32 v118, v12, v105
    v_fmac_f32 v118, v14, v107
    v_fmac_f32 v118, v16, v109
    v_fmac_f32 v118, v18, v111
    v_fmac_f32 v118, v20, v113
    v_fmac_f32 v118, v22, v115
    s_cbranch_execz L_sx_e
    s_cmp_eq_u64 s[60:61], 0
    s_mov_b64 exec, 0xff
    s_cbranch_scc0 L_st_slow
    global_store_dwordx4 v1, v[116:119], s[26:27] offset:1024
    s_branch L_st_e
L_st_slow:
    global_store_dwordx4 v1, v[116:119], s[26:27] offset:1024 sc1
L_st_e:
    s_mov_b64 exec, -1
L_sx_e:
    v_mov_b32 v9, v8
    v_mov_b32 v11, v10
    v_mov_b32 v13, v12
    v_mov_b32 v15, v14
    v_mov_b32 v17, v16
    v_mov_b32 v19, v18
    v_mov_b32 v21, v20
    v_mov_b32 v23, v22
    s_cmp_eq_u64 s[60:61], 0
    s_cbranch_execz L_w0_spin2
L_w0_spin1:
    ds_read_b32 v5, v4 offset:2888
    s_waitcnt lgkmcnt(0)
    v_cmp_gt_u32 vcc, 5, v5
    s_cbranch_vccnz L_w0_spin1
L_w0_spin2:
    ds_read_b32 v5, v4 offset:2888
    ds_read2st64_b64 v[100:103], v3 offset0:6 offset1:7
    ds_read2st64_b64 v[104:107], v3 offset0:8 offset1:9
    ds_read2st64_b64 v[108:111], v3 offset0:10 offset1:11
    ds_read2st64_b64 v[112:115], v3 offset0:12 offset1:13
    s_waitcnt lgkmcnt(4)
    v_cmp_ne_u32 vcc, 8, v5
    s_cbranch_vccnz L_w0_spin2
    s_waitcnt lgkmcnt(2)
    v_pk_mul_f32 v[100:101], v[100:101], v[8:9]
    v_pk_mul_f32 v[102:103], v[102:103], v[10:11]
    v_pk_fma_f32 v[100:101], v[104:105], v[12:13], v[100:101]
    v_pk_fma_f32 v[102:103], v[106:107], v[14:15], v[102:103]
    s_waitcnt lgkmcnt(0)
    v_pk_fma_f32 v[100:101], v[108:109], v[16:17], v[100:101]
    v_pk_fma_f32 v[102:103], v[110:111], v[18:19], v[102:103]
    v_pk_fma_f32 v[100:101], v[112:113], v[20:21], v[100:101]
    v_pk_fma_f32 v[102:103], v[114:115], v[22:23], v[102:103]
    v_add_f32 v120, v100, v102
    v_add_f32 v122, v101, v103
    s_cbranch_execz L_exit
    s_cbranch_scc0 L_pubB_slow
    global_store_dwordx4 v1, v[120:123], s[26:27]
L_pubB_e:
    ds_write_b32 v4, v5 offset:2892
    s_barrier
    s_branch L_exit
L_pubB_slow:
    global_store_dwordx4 v1, v[120:123], s[26:27] sc1
    s_branch L_pubB_e
L_not0:
    s_lshl_b32 s50, s29, 2
    s_lshr_b32 s40, s2, 6
    s_add_u32 s50, s50, s40
    s_and_b32 s41, s2, 7
    s_mul_i32 s51, s41, 12
    s_sub_u32 s50, s50, s51
    s_add_u32 s50, s50, 64
    s_cmp_ge_u32 s3, 2
    s_cbranch_scc1 L_att
    s_cmp_eq_u32 s2, 239
    s_cbranch_scc1 L_init
    s_lshl_b32 s39, s29, 2
    s_lshr_b32 s39, 0x56743210, s39
    s_and_b32 s39, s39, 7
    s_lshl_b32 s39, s39, 2
    s_add_u32 s39, s39, s40
    s_cmp_ge_u32 s39, 27
    s_cbranch_scc1 L_exit
    s_lshr_b32 s40, s41, 2
    s_and_b32 s41, s41, 3
    s_mul_i32 s41, s41, 27
    s_add_u32 s39, s39, s41
    s_and_b32 s37, s39, 3
    s_lshr_b32 s39, s39, 2
    s_lshl_b32 s38, s39, 7
    s_mov_b32 s34, 3456
    s_lshl_b32 s41, s40, 2
    s_add_u32 s41, s41, s37
    s_mul_i32 s35, s41, 27648
    s_lshl_b32 s41, s39, 9
    s_add_u32 s35, s35, s41
    s_add_u32 s35, s35, 393216
    s_mov_b32 s36, 13824
    s_branch L_p1
L_init:
    v_lshlrev_b32 v1, 4, v0
    v_add_u32 v1, 1048576, v1
    v_mov_b32 v4, 0
    v_mov_b32 v5, 0
    v_mov_b32 v6, 0
    v_mov_b32 v7, 0
    s_mov_b32 s44, 4096
    v_lshl_add_u32 v2, v0, 2, s44
    s_waitcnt lgkmcnt(0)
    global_store_dwordx4 v1, v[4:7], s[26:27] offset:0 sc1
    global_store_dwordx4 v1, v[4:7], s[26:27] offset:1024 sc1
    global_store_dwordx4 v1, v[4:7], s[26:27] offset:2048 sc1
    global_store_dwordx4 v1, v[4:7], s[26:27] offset:3072 sc1
    v_add_u32 v1, 4096, v1
    global_store_dwordx4 v1, v[4:7], s[26:27] offset:0 sc1
    global_store_dwordx4 v1, v[4:7], s[26:27] offset:1024 sc1
    global_store_dwordx4 v1, v[4:7], s[26:27] offset:2048 sc1
    global_store_dwordx4 v1, v[4:7], s[26:27] offset:3072 sc1
    v_add_u32 v1, 4096, v1
    global_store_dwordx4 v1, v[4:7], s[26:27] offset:0 sc1
    global_store_dwordx4 v1, v[4:7], s[26:27] offset:1024 sc1
    global_store_dwordx4 v1, v[4:7], s[26:27] offset:2048 sc1
    global_store_dwordx4 v1, v[4:7], s[26:27] offset:3072 sc1
    v_add_u32 v1, 4096, v1
    global_store_dwordx4 v1, v[4:7], s[26:27] offset:0 sc1
    global_store_dwordx4 v1, v[4:7], s[26:27] offset:1024 sc1
    global_store_dwordx4 v1, v[4:7], s[26:27] offset:2048 sc1
    s_load_dword s30, s[26:27], 0
    s_waitcnt vmcnt(0) lgkmcnt(0)
    s_mul_i32 s30, s30, 0x9E3779B1
    s_add_u32 s30, s30, 0x7F4A7C15
    v_mov_b32 v3, s30
    global_store_dword v2, v3, s[26:27] sc1
    s_branch L_exit
L_att:
    s_cmp_lt_u32 s3, 11
    s_cbranch_scc1 L_att_addr
    s_mov_b64 exec, 0
    s_branch L_p1_dry
L_att_addr:
    s_and_b32 s31, s2, 32
    s_add_u32 s31, s31, s28
    s_lshl_b32 s31, s31, 20
    s_add_u32 s31, s31, 0xC0000
    s_and_b32 s32, s29, 3
    s_lshl_b32 s32, s32, 8
    s_add_u32 s31, s31, s32
    s_sub_u32 s33, s3, 2
    s_and_b32 s33, s33, 7
    s_and_b32 s32, s33, 3
    s_lshl_b32 s32, s32, 11
    s_add_u32 s31, s31, s32
    s_lshr_b32 s32, s33, 2
    s_lshl_b32 s32, s32, 10
    s_add_u32 s31, s31, s32
    v_lshl_add_u32 v1, v0, 4, s31
    v_lshrrev_b32 v2, 4, v0
    v_mul_u32_u24 v3, 7936, v2
    v_add_u32 v96, v1, v3
    v_xor_b32 v97, 0x8100, v96
    v_xor_b32 v98, 0x10200, v96
    v_xor_b32 v99, 0x18300, v96
    v_xor_b32 v100, 0x20000, v96
    v_xor_b32 v101, 0x28100, v96
    v_xor_b32 v102, 0x30200, v96
    v_xor_b32 v103, 0x38300, v96
    v_and_b32 v4, 1, v0
    v_lshlrev_b32 v4, 1, v4
    s_mov_b32 s56, 0x0c0c0100
    s_mov_b32 s57, 0x0c0c0302
    v_alignbyte_b32 v5, s56, s56, v4
    v_alignbyte_b32 v6, s57, s57, v4
    v_mov_b32 v4, 0x0c0c0c0c
    s_mov_b32 s56, 0x3030303
    s_mov_b32 s57, 0x3030303
    v_cndmask_b32 v8, v4, v5, s[56:57]
    v_cndmask_b32 v9, v4, v6, s[56:57]
    s_mov_b32 s56, 0xc0c0c0c
    s_mov_b32 s57, 0xc0c0c0c
    v_cndmask_b32 v10, v4, v5, s[56:57]
    v_cndmask_b32 v11, v4, v6, s[56:57]
    s_mov_b32 s56, 0x30303030
    s_mov_b32 s57, 0x30303030
    v_cndmask_b32 v12, v4, v5, s[56:57]
    v_cndmask_b32 v13, v4, v6, s[56:57]
    s_mov_b32 s56, 0xc0c0c0c0
    s_mov_b32 s57, 0xc0c0c0c0
    v_cndmask_b32 v14, v4, v5, s[56:57]
    v_cndmask_b32 v15, v4, v6, s[56:57]
    v_and_b32 v3, 15, v0
    v_mul_u32_u24 v112, 5120, v2
    v_lshl_add_u32 v112, v3, 4, v112
    s_cmp_ge_u32 s29, 5
    s_cbranch_scc1 L_addr_d
    s_mov_b32 s51, 0
    s_mov_b32 s31, s29
    s_lshl_b32 s34, s28, 7
    v_bfe_u32 v5, v0, 3, 1
    v_lshl_add_u32 v5, v5, 2, v2
    v_mul_u32_u24 v5, 1152, v5
    s_mul_i32 s35, s28, 9216
    s_add_u32 s35, s35, 655360
    v_and_b32 v6, 7, v0
    v_lshlrev_b32 v6, 4, v6
    v_add3_u32 v114, v6, v5, s35
    s_lshl_b32 s36, s33, 7
    v_add_u32 v113, s36, v114
    s_branch L_addr_c
L_addr_d:
    s_mul_hi_u32 s35, s50, 0x33333334
    s_mul_i32 s36, s35, 5
    s_sub_u32 s31, s50, s36
    s_lshl_b32 s34, s35, 4
    s_mul_i32 s36, s33, 272
    s_add_u32 s34, s34, s36
    s_cmp_ge_u32 s33, 6
    s_cselect_b32 s51, 2, 1
    s_cmp_ge_u32 s50, 90
    s_cselect_b32 s51, 3, s51
    v_lshrrev_b32 v5, 3, v0
    v_mul_u32_u24 v5, 27648, v5
    v_and_b32 v6, 7, v0
    v_lshlrev_b32 v6, 4, v6
    s_lshl_b32 s35, s33, 4
    s_add_u32 s35, s35, s34
    s_lshl_b32 s35, s35, 3
    s_add_u32 s35, s35, 393216
    v_add3_u32 v113, v6, v5, s35
    v_add_u32 v114, 13824, v113
L_addr_c:
    s_lshl_b32 s35, s33, 4
    s_add_u32 s34, s34, s35
    s_mul_i32 s34, s34, 1280
    s_lshl_b32 s35, s31, 8
    s_add_u32 s34, s34, s35
    v_add_u32 v112, s34, v112
    s_waitcnt lgkmcnt(0)
    s_cmp_lt_u32 s3, 10
    s_cbranch_scc1 L_w1go
    s_cmp_eq_u32 s51, 0
    s_cselect_b64 s[36:37], s[12:13], s[20:21]
    s_cselect_b32 s35, 8, 0x5b
    s_mul_i32 s35, s35, 20480
    s_sub_u32 s35, s35, 1280
    s_cmp_eq_u32 s51, 3
    s_cselect_b32 s34, 0, s34
    s_add_u32 s35, s35, s34
    s_mov_b64 exec, 1
    v_mov_b32 v16, s34
    v_mov_b32 v17, s35
    v_mov_b32 v18, 0
    global_load_dword v20, v96, s[8:9] nt
    global_load_dword v21, v16, s[36:37] nt
    global_load_dword v22, v17, s[36:37] nt
    global_load_ushort v23, v18, s[22:23]
    global_load_dword v24, v18, s[26:27] offset:64
    s_mov_b64 exec, -1
    s_branch L_w1skip
L_w1go:
    global_load_dwordx4 v[16:19], v96, s[6:7] nt
    global_load_dwordx4 v[20:23], v97, s[6:7] nt
    s_load_dword s30, s[26:27], 0
L_w1skip:
    v_mov_b32 v115, 4096
    v_lshlrev_b32 v116, 4, v3
    v_and_b32 v107, 8, v0
    v_lshl_add_u32 v107, v2, 1, v107
    v_lshlrev_b32 v107, 2, v107
    v_and_b32 v2, 1, v2
    v_lshlrev_b32 v117, 5, v3
    v_lshl_add_u32 v117, v2, 4, v117
    v_lshrrev_b32 v119, 5, v0
    v_lshl_add_u32 v119, v119, 9, v117
    s_lshl_b32 s35, s33, 10
    v_add_u32 v119, s35, v119
    s_lshl_b32 s35, s33, 9
    v_add_u32 v117, s35, v117
    s_lshl_b32 s35, s33, 3
    v_mov_b32 v118, s35
    v_mov_b32 v7, 0
    s_lshl_b32 s34, s33, 6
    v_add_u32 v5, s34, v0
    v_lshrrev_b32 v2, 2, v5
    v_and_b32 v3, 3, v5
    v_mad_u32_u24 v2, v2, 3, v3
    v_cmp_eq_u32 s[44:45], 3, v3
    s_movk_i32 s36, 256
    v_cmp_gt_u32 s[46:47], s36, v2
    v_cmp_gt_u32 vcc, 344, v5
    s_mul_i32 s34, s31, 3072
    s_add_u32 s34, s34, 1048576
    v_lshrrev_b32 v120, 4, v5
    v_lshlrev_b32 v120, 7, v120
    v_and_b32 v4, 15, v5
    v_lshl_add_u32 v120, v4, 2, v120
    v_add_u32 v120, s34, v120
    v_and_b32 v2, 255, v2
    v_lshrrev_b32 v4, 7, v2
    v_mul_u32_u24 v4, 1280, v4
    v_and_b32 v5, 127, v2
    v_lshl_add_u32 v4, v5, 1, v4
    s_lshl_b32 s34, s31, 8
    v_add_u32 v121, s34, v4
    v_lshlrev_b32 v122, 2, v2
    s_and_b64 s[48:49], vcc, s[44:45]
    s_andn2_b64 s[46:47], s[46:47], s[44:45]
    s_or_b64 s[48:49], s[48:49], s[46:47]
    s_mov_b32 s42, 0x3fb8aa3b
    s_mov_b32 s43, 0x3DB504F3
    s_mov_b32 s41, 0
    s_cmp_lt_u32 s3, 10
    s_cbranch_scc1 L_live
    s_mov_b64 exec, 0
L_live:
    s_cbranch_execz L_sk_7
    s_waitcnt vmcnt(1)
    global_load_dwordx4 v[24:27], v98, s[6:7] nt
    global_load_dwordx4 v[28:31], v99, s[6:7] nt
    s_waitcnt vmcnt(3)
    global_load_dwordx4 v[32:35], v100, s[6:7] nt
    s_waitcnt vmcnt(3)
    global_load_dwordx4 v[36:39], v101, s[6:7] nt
    s_waitcnt vmcnt(3)
L_sk_7:
    s_cbranch_execz L_sk_8
    global_load_dwordx4 v[40:43], v102, s[6:7] nt
    s_waitcnt vmcnt(3)
    global_load_dwordx4 v[44:47], v103, s[6:7] nt
    s_waitcnt vmcnt(3)
    global_load_dwordx4 v[48:51], v96, s[8:9] nt
    s_waitcnt vmcnt(3)
    global_load_dwordx4 v[52:55], v97, s[8:9] nt
    s_waitcnt vmcnt(3)
L_sk_8:
    s_cbranch_execz L_sk_9
    global_load_dwordx4 v[56:59], v98, s[8:9] nt
    s_waitcnt vmcnt(3)
    global_load_dwordx4 v[60:63], v99, s[8:9] nt
L_sk_9:
    s_cbranch_execz L_sk_10
    global_load_dwordx4 v[64:67], v100, s[8:9] nt
    global_load_ushort v123, v121, s[4:5]
    s_waitcnt lgkmcnt(0)
    s_mul_i32 s30, s30, 0x9E3779B1
    s_add_u32 s30, s30, 0x7F4A7C15
L_sk_10:
    s_waitcnt vmcnt(6)
    s_branch L_q1
L_q0:
    s_sleep 1
L_q1:
    ds_read_b32 v124, v7 offset:2880
    ds_read_b128 v[108:111], v116 offset:2560
    s_waitcnt lgkmcnt(0)
    v_cmp_eq_u32 vcc, 0, v124
    s_cbranch_vccnz L_q0
    v_dot2_f32_bf16 v124, v16, v108, 0
    v_dot2_f32_bf16 v125, v20, v108, 0
    v_dot2_f32_bf16 v126, v24, v108, 0
    v_dot2_f32_bf16 v127, v28, v108, 0
    v_dot2_f32_bf16 v128, v32, v108, 0
    v_dot2_f32_bf16 v129, v36, v108, 0
    v_dot2_f32_bf16 v130, v40, v108, 0
    v_dot2_f32_bf16 v131, v44, v108, 0
    v_dot2_f32_bf16 v124, v17, v109, v124
    v_dot2_f32_bf16 v125, v21, v109, v125
    v_dot2_f32_bf16 v126, v25, v109, v126
    v_dot2_f32_bf16 v127, v29, v109, v127
    v_dot2_f32_bf16 v128, v33, v109, v128
    v_dot2_f32_bf16 v129, v37, v109, v129
    v_dot2_f32_bf16 v130, v41, v109, v130
    v_dot2_f32_bf16 v131, v45, v109, v131
    v_dot2_f32_bf16 v124, v18, v110, v124
    v_dot2_f32_bf16 v125, v22, v110, v125
    v_dot2_f32_bf16 v126, v26, v110, v126
    v_dot2_f32_bf16 v127, v30, v110, v127
    v_dot2_f32_bf16 v128, v34, v110, v128
    v_dot2_f32_bf16 v129, v38, v110, v129
    v_dot2_f32_bf16 v130, v42, v110, v130
    v_dot2_f32_bf16 v131, v46, v110, v131
    v_dot2_f32_bf16 v124, v19, v111, v124
    v_dot2_f32_bf16 v125, v23, v111, v125
    v_dot2_f32_bf16 v126, v27, v111, v126
    v_dot2_f32_bf16 v127, v31, v111, v127
    v_dot2_f32_bf16 v128, v35, v111, v128
    v_dot2_f32_bf16 v129, v39, v111, v129
    v_dot2_f32_bf16 v130, v43, v111, v130
    v_dot2_f32_bf16 v131, v47, v111, v131
    s_cbranch_execz L_sk_11
    global_load_dwordx4 v[68:71], v101, s[8:9] nt
L_sk_11:
    v_add_f32 v132, v124, v124 row_ror:8
    v_add_f32 v133, v125, v125 row_ror:8
    v_add_f32 v134, v126, v126 row_ror:8
    v_add_f32 v135, v127, v127 row_ror:8
    v_add_f32 v132, v128, v128 row_ror:8 bank_mask:0xc
    v_add_f32 v133, v129, v129 row_ror:8 bank_mask:0xc
    v_add_f32 v134, v130, v130 row_ror:8 bank_mask:0xc
    v_add_f32 v135, v131, v131 row_ror:8 bank_mask:0xc
    v_add_f32 v124, v132, v132 row_half_mirror
    v_add_f32 v125, v133, v133 row_half_mirror
    s_nop 0
    v_add_f32 v124, v134, v134 row_half_mirror bank_mask:0xa
    v_add_f32 v125, v135, v135 row_half_mirror bank_mask:0xa
    s_nop 0
    v_add_f32 v124, v124, v124 quad_perm:[2,3,0,1]
    v_add_f32 v125, v125, v125 quad_perm:[2,3,0,1]
    s_nop 0
    v_add_f32 v124, v124, v124 quad_perm:[1,0,3,2]
    v_add_f32 v125, v125, v125 quad_perm:[1,0,3,2]
    v_cvt_pk_bf16_f32 v126, v124, v125
    v_lshlrev_b32 v124, 16, v126
    v_and_b32 v125, 0xffff0000, v126
    v_mul_f32 v124, s43, v124
    v_mul_f32 v125, s43, v125
    v_cvt_pk_bf16_f32 v126, v124, v125
    v_lshlrev_b32 v124, 16, v126
    v_and_b32 v125, 0xffff0000, v126
    v_max_f32 v134, v124, v125
    s_nop 1
    v_max_f32 v134, v134, v134 row_ror:4
    s_nop 1
    v_max_f32 v134, v134, v134 row_ror:8
    v_mov_b32 v126, v134
    s_nop 1
    v_permlane16_swap_b32 v134, v126
    v_max_f32 v134, v134, v126
    v_mov_b32 v126, v134
    s_nop 1
    v_permlane32_swap_b32 v134, v126
    v_max_f32 v134, v134, v126
    s_cbranch_execz L_sk_12
    global_load_dwordx4 v[72:75], v102, s[8:9] nt
L_sk_12:
    v_sub_f32 v124, v124, v134
    v_sub_f32 v125, v125, v134
    v_mul_f32 v124, s42, v124
    v_mul_f32 v125, s42, v125
    v_exp_f32 v124, v124
    v_exp_f32 v125, v125
    s_nop 0
    v_cvt_pk_bf16_f32 v126, v124, v125
    v_add_f32 v135, v124, v125
    s_nop 0
    v_mov_b32 v128, v126 row_newbcast:0
    v_mov_b32 v129, v126 row_newbcast:4
    v_mov_b32 v130, v126 row_newbcast:8
    v_mov_b32 v131, v126 row_newbcast:12
    v_add_f32 v135, v135, v135 row_ror:4
    s_nop 1
    v_add_f32 v135, v135, v135 row_ror:8
    v_perm_b32 v16, v128, v128, v8
    v_perm_b32 v17, v128, v128, v10
    v_perm_b32 v18, v128, v128, v12
    v_perm_b32 v19, v128, v128, v14
    v_perm_b32 v20, v128, v128, v9
    v_perm_b32 v21, v128, v128, v11
    v_perm_b32 v22, v128, v128, v13
    v_perm_b32 v23, v128, v128, v15
    v_perm_b32 v24, v129, v129, v8
    v_perm_b32 v25, v129, v129, v10
    v_perm_b32 v26, v129, v129, v12
    v_perm_b32 v27, v129, v129, v14
    v_perm_b32 v28, v129, v129, v9
    v_perm_b32 v29, v129, v129, v11
    v_perm_b32 v30, v129, v129, v13
    v_perm_b32 v31, v129, v129, v15
    v_perm_b32 v32, v130, v130, v8
    v_perm_b32 v33, v130, v130, v10
    v_perm_b32 v34, v130, v130, v12
    v_perm_b32 v35, v130, v130, v14
    v_perm_b32 v36, v130, v130, v9
    v_perm_b32 v37, v130, v130, v11
    v_perm_b32 v38, v130, v130, v13
    v_perm_b32 v39, v130, v130, v15
    v_perm_b32 v40, v131, v131, v8
    v_perm_b32 v41, v131, v131, v10
    v_perm_b32 v42, v131, v131, v12
    v_perm_b32 v43, v131, v131, v14
    v_perm_b32 v44, v131, v131, v9
    v_perm_b32 v45, v131, v131, v11
    v_perm_b32 v46, v131, v131, v13
    v_perm_b32 v47, v131, v131, v15
    s_cbranch_execz L_sk_13
    global_load_dwordx4 v[76:79], v103, s[8:9] nt
L_sk_13:
    v_mov_b32 v126, v135
    s_nop 1
    v_permlane16_swap_b32 v135, v126
    v_add_f32 v135, v135, v126
    v_mov_b32 v126, v135
    s_nop 1
    v_permlane32_swap_b32 v135, v126
    v_add_f32 v135, v135, v126
    v_mov_b32 v126, 1
    s_mov_b64 s[52:53], exec
    s_and_b64 exec, exec, 1
    ds_write_b64 v118, v[134:135] offset:2816
    ds_add_u32 v7, v126 offset:2884
    s_mov_b64 exec, s[52:53]
    s_cmp_eq_u32 s51, 0
    s_cbranch_scc1 L_pv_o
    s_waitcnt vmcnt(8)
    v_mfma_f32_16x16x32_bf16 v[108:111], v[16:19], v[48:51], 0
    s_waitcnt vmcnt(7)
    v_mfma_f32_16x16x32_bf16 v[108:111], v[20:23], v[52:55], v[108:111]
    s_waitcnt vmcnt(6)
    v_mfma_f32_16x16x32_bf16 v[108:111], v[24:27], v[56:59], v[108:111]
    s_waitcnt vmcnt(5)
    v_mfma_f32_16x16x32_bf16 v[108:111], v[28:31], v[60:63], v[108:111]
    s_waitcnt vmcnt(4)
    v_mfma_f32_16x16x32_bf16 v[108:111], v[32:35], v[64:67], v[108:111]
    s_waitcnt vmcnt(2)
    v_mfma_f32_16x16x32_bf16 v[108:111], v[36:39], v[68:71], v[108:111]
    s_waitcnt vmcnt(1)
    v_mfma_f32_16x16x32_bf16 v[108:111], v[40:43], v[72:75], v[108:111]
    s_waitcnt vmcnt(0)
    v_mfma_f32_16x16x32_bf16 v[108:111], v[44:47], v[76:79], v[108:111]
    s_nop 7
    ds_write_b128 v117, v[108:111] offset:3072
    s_and_b64 exec, exec, 1
    ds_add_u32 v7, v126 offset:2888
    s_mov_b64 exec, s[52:53]
    s_cmp_eq_u32 s51, 1
    s_cbranch_scc1 L_pubwd
    s_cmp_eq_u32 s51, 3
    s_cbranch_scc1 L_exit
    v_mov_b32 v108, 0
    v_mov_b32 v109, 0
    v_mov_b32 v110, 0
    v_mov_b32 v111, 0
    s_branch L_p3_out
L_pubwd:
    ds_read_b32 v105, v7 offset:2888
    s_waitcnt lgkmcnt(0)
    v_cmp_gt_u32 vcc, 6, v105
    s_cbranch_vccnz L_pubwd
    s_cbranch_execz L_sk_14
    global_load_dwordx4 v[96:99], v113, s[26:27] sc1
    global_load_dwordx4 v[100:103], v114, s[26:27] sc1
    global_load_dword v104, v115, s[26:27] sc1
    global_load_dwordx4 v[80:83], v112, s[20:21] offset:0 nt
    global_load_dwordx4 v[84:87], v112, s[20:21] offset:1280 nt
    global_load_dwordx4 v[88:91], v112, s[20:21] offset:2560 nt
    global_load_dwordx4 v[92:95], v112, s[20:21] offset:3840 nt
L_sk_14:
    s_waitcnt vmcnt(4)
    s_branch L_pollF_chk
L_pollF:
    global_load_dwordx4 v[96:99], v113, s[26:27] sc1
    global_load_dwordx4 v[100:103], v114, s[26:27] sc1
    global_load_dword v104, v115, s[26:27] sc1
    s_add_u32 s41, s41, 1
    s_waitcnt vmcnt(0)
L_pollF_chk:
    v_xor_b32 v16, s30, v97
    v_xor_b32 v17, s30, v99
    v_xor_b32 v18, s30, v101
    v_xor_b32 v19, s30, v103
    v_xor_b32 v20, s30, v104
    v_or3_b32 v16, v16, v17, v18
    v_or3_b32 v16, v16, v19, v20
    v_cmp_ne_u32 vcc, 0, v16
    s_mov_b64 exec, vcc
    s_cmp_ge_u32 s41, 400000
    s_cbranch_scc1 L_pollF_done
    s_cbranch_vccnz L_pollF
L_pollF_done:
    s_mov_b64 exec, s[52:53]
    v_add_f32 v96, v96, v96 row_ror:8
    v_add_f32 v98, v98, v98 row_ror:8
    v_add_f32 v100, v100, v100 row_ror:8
    v_add_f32 v102, v102, v102 row_ror:8
    v_mov_b32 v97, v96
    v_mov_b32 v99, v98
    v_mov_b32 v101, v100
    v_mov_b32 v103, v102
    v_permlane16_swap_b32 v96, v97
    v_permlane16_swap_b32 v98, v99
    v_permlane16_swap_b32 v100, v101
    v_permlane16_swap_b32 v102, v103
    v_add_f32 v96, v96, v97
    v_add_f32 v98, v98, v99
    v_add_f32 v100, v100, v101
    v_add_f32 v102, v102, v103
    s_mov_b32 s56, 0xff00ff00
    s_mov_b32 s57, 0xff00ff00
    v_cndmask_b32 v96, v96, v100, s[56:57]
    v_cndmask_b32 v98, v98, v102, s[56:57]
    v_cvt_pk_bf16_f32 v104, v96, v98
    v_mov_b32 v105, v104
    s_nop 1
    v_permlane32_swap_b32 v104, v105
    v_lshlrev_b32 v96, 16, v104
    v_and_b32 v98, 0xffff0000, v104
    s_mov_b32 s42, 0xbdd2d3e8
    v_mov_b32 v106, 0xc0135761
    v_mul_f32 v97, v96, v96
    v_mul_f32 v99, v98, v98
    v_fma_f32 v97, v97, s42, v106
    v_fma_f32 v99, v99, s42, v106
    v_mul_f32 v97, v97, v96
    v_mul_f32 v99, v99, v98
    v_exp_f32 v97, v97
    v_exp_f32 v99, v99
    v_lshlrev_b32 v100, 16, v105
    v_and_b32 v102, 0xffff0000, v105
    v_add_f32 v97, 1.0, v97
    v_add_f32 v99, 1.0, v99
    v_rcp_f32 v97, v97
    v_rcp_f32 v99, v99
    v_mul_f32 v96, v96, v97
    v_mul_f32 v98, v98, v99
    v_cvt_pk_bf16_f32 v104, v96, v98
    v_lshlrev_b32 v96, 16, v104
    v_and_b32 v98, 0xffff0000, v104
    v_mul_f32 v96, v96, v100
    v_mul_f32 v98, v98, v102
    v_cvt_pk_bf16_f32 v106, v96, v98
    ds_bpermute_b32 v104, v107, v106
    ds_bpermute_b32 v105, v107, v106 offset:4
    s_waitcnt lgkmcnt(0)
    v_perm_b32 v16, v104, v104, v8
    v_perm_b32 v17, v104, v104, v10
    v_perm_b32 v18, v104, v104, v12
    v_perm_b32 v19, v104, v104, v14
    v_perm_b32 v20, v104, v104, v9
    v_perm_b32 v21, v104, v104, v11
    v_perm_b32 v22, v104, v104, v13
    v_perm_b32 v23, v104, v104, v15
    v_perm_b32 v24, v105, v105, v8
    v_perm_b32 v25, v105, v105, v10
    v_perm_b32 v26, v105, v105, v12
    v_perm_b32 v27, v105, v105, v14
    v_perm_b32 v28, v105, v105, v9
    v_perm_b32 v29, v105, v105, v11
    v_perm_b32 v30, v105, v105, v13
    v_perm_b32 v31, v105, v105, v15
    s_waitcnt vmcnt(3)
    v_mfma_f32_16x16x32_bf16 v[108:111], v[16:19], v[80:83], 0
    s_waitcnt vmcnt(2)
    v_mfma_f32_16x16x32_bf16 v[108:111], v[20:23], v[84:87], v[108:111]
    s_waitcnt vmcnt(1)
    v_mfma_f32_16x16x32_bf16 v[108:111], v[24:27], v[88:91], v[108:111]
    s_waitcnt vmcnt(0)
    v_mfma_f32_16x16x32_bf16 v[108:111], v[28:31], v[92:95], v[108:111]
    s_nop 6
    s_branch L_p3_out
L_pv_o:
    s_waitcnt vmcnt(8)
    v_mfma_f32_16x16x32_bf16 v[108:111], v[16:19], v[48:51], 0
    s_waitcnt vmcnt(7)
    v_mfma_f32_16x16x32_bf16 v[108:111], v[20:23], v[52:55], v[108:111]
    s_waitcnt vmcnt(6)
    v_mfma_f32_16x16x32_bf16 v[108:111], v[24:27], v[56:59], v[108:111]
    s_waitcnt vmcnt(5)
    v_mfma_f32_16x16x32_bf16 v[108:111], v[28:31], v[60:63], v[108:111]
    s_waitcnt vmcnt(4)
    v_mfma_f32_16x16x32_bf16 v[108:111], v[32:35], v[64:67], v[108:111]
    s_cbranch_execz L_sk_15
    global_load_dword v104, v115, s[26:27] sc1
    global_load_dwordx4 v[80:83], v112, s[12:13] offset:0 nt
L_sk_15:
    s_waitcnt vmcnt(4)
    v_mfma_f32_16x16x32_bf16 v[108:111], v[36:39], v[68:71], v[108:111]
    s_cbranch_execz L_sk_16
    global_load_dwordx4 v[84:87], v112, s[12:13] offset:1280 nt
L_sk_16:
    s_waitcnt vmcnt(4)
    v_mfma_f32_16x16x32_bf16 v[108:111], v[40:43], v[72:75], v[108:111]
    s_cbranch_execz L_sk_17
    global_load_dwordx4 v[88:91], v112, s[12:13] offset:2560 nt
L_sk_17:
    s_waitcnt vmcnt(4)
    v_mfma_f32_16x16x32_bf16 v[108:111], v[44:47], v[76:79], v[108:111]
    s_cbranch_execz L_sk_18
    global_load_dwordx4 v[92:95], v112, s[12:13] offset:3840 nt
L_sk_18:
    s_nop 5
    ds_write_b128 v117, v[108:111] offset:3072
    s_and_b64 exec, exec, 1
    ds_add_u32 v7, v126 offset:2888
    s_mov_b64 exec, s[52:53]
    s_cbranch_execz L_pollB_chk
    s_waitcnt vmcnt(4)
    v_cmp_ne_u32 vcc, s30, v104
    s_cbranch_vccz L_pubw
L_flag:
    global_load_dword v104, v115, s[26:27] sc1
    s_add_u32 s41, s41, 1
    s_waitcnt vmcnt(0)
    v_cmp_ne_u32 vcc, s30, v104
    s_cmp_ge_u32 s41, 400000
    s_cbranch_scc1 L_pubw
    s_cbranch_vccnz L_flag
L_pubw:
    ds_read_b32 v105, v7 offset:2892
    s_waitcnt lgkmcnt(0)
    v_cmp_eq_u32 vcc, 0, v105
    s_cbranch_vccnz L_pubw
L_pollS:
    global_load_dwordx4 v[100:103], v114, s[26:27] offset:1024 sc1
    global_load_dwordx4 v[96:99], v113, s[26:27] sc1
    s_add_u32 s41, s41, 1
    s_cmp_ge_u32 s41, 400000
    s_waitcnt vmcnt(0)
L_pollB_chk:
    v_cmp_ne_u32 vcc, s30, v101
    v_cmp_ne_u32 s[54:55], s30, v103
    v_mov_b32 v105, v100
    v_mov_b32 v106, v100
    s_cbranch_scc1 L_pollB_go
    s_or_b64 vcc, vcc, s[54:55]
    s_cbranch_scc1 L_pollS
    v_permlane16_swap_b32 v105, v106
    v_cmp_ne_u32 vcc, s30, v97
    v_cmp_ne_u32 s[54:55], s30, v99
    v_max_f32 v105, v105, v106
    v_mov_b32 v106, v105
    s_nop 1
    v_permlane32_swap_b32 v105, v106
    v_max_f32 v105, v105, v106
    v_sub_f32 v105, v100, v105
    v_mul_f32 v105, s42, v105
    v_exp_f32 v105, v105
    s_nop 0
    v_mul_f32 v102, v105, v102
    v_mov_b32 v103, v102
    s_nop 1
    v_permlane16_swap_b32 v102, v103
    v_add_f32 v102, v102, v103
    v_mov_b32 v103, v102
    s_nop 1
    v_permlane32_swap_b32 v102, v103
    v_add_f32 v102, v102, v103
    v_rcp_f32 v102, v102
    s_or_b64 s[54:55], vcc, s[54:55]
    v_mul_f32 v105, v105, v102
    s_cbranch_scc0 L_pollB_go
    s_mov_b64 exec, s[54:55]
L_pollB:
    global_load_dwordx4 v[96:99], v113, s[26:27] sc1
    s_add_u32 s41, s41, 1
    s_cmp_ge_u32 s41, 400000
    s_waitcnt vmcnt(0)
    v_cmp_ne_u32 vcc, s30, v97
    v_cmp_ne_u32 s[54:55], s30, v99
    s_cbranch_scc1 L_pollB_done
    s_or_b64 exec, vcc, s[54:55]
    s_cbranch_execnz L_pollB
L_pollB_done:
    s_mov_b64 exec, -1
L_pollB_go:
    v_mul_f32 v96, v96, v105
    v_mul_f32 v98, v98, v105
    s_nop 1
    v_permlane32_swap_b32 v96, v98
    v_add_f32 v96, v96, v98
    v_mov_b32 v97, v96
    s_nop 1
    v_permlane16_swap_b32 v96, v97
    v_add_f32 v96, v96, v97
    v_cvt_pk_bf16_f32 v106, v96, v96
    ds_bpermute_b32 v100, v107, v106
    ds_bpermute_b32 v101, v107, v106 offset:128
    ds_bpermute_b32 v102, v107, v106 offset:4
    ds_bpermute_b32 v103, v107, v106 offset:132
    s_waitcnt lgkmcnt(3)
    v_perm_b32 v16, v100, v100, v8
    v_perm_b32 v17, v100, v100, v10
    v_perm_b32 v18, v100, v100, v12
    v_perm_b32 v19, v100, v100, v14
    s_waitcnt lgkmcnt(2)
    v_perm_b32 v20, v101, v101, v8
    v_perm_b32 v21, v101, v101, v10
    v_perm_b32 v22, v101, v101, v12
    v_perm_b32 v23, v101, v101, v14
    v_mfma_f32_16x16x32_bf16 v[108:111], v[16:19], v[80:83], 0
    s_waitcnt lgkmcnt(1)
    v_perm_b32 v24, v102, v102, v8
    v_perm_b32 v25, v102, v102, v10
    v_perm_b32 v26, v102, v102, v12
    v_perm_b32 v27, v102, v102, v14
    v_mfma_f32_16x16x32_bf16 v[108:111], v[20:23], v[84:87], v[108:111]
    s_waitcnt lgkmcnt(0)
    v_perm_b32 v28, v103, v103, v8
    v_perm_b32 v29, v103, v103, v10
    v_perm_b32 v30, v103, v103, v12
    v_perm_b32 v31, v103, v103, v14
    v_mfma_f32_16x16x32_bf16 v[108:111], v[24:27], v[88:91], v[108:111]
    s_nop 0
    v_mfma_f32_16x16x32_bf16 v[108:111], v[28:31], v[92:95], v[108:111]
    s_nop 7
L_p3_out:
    ds_write_b128 v119, v[108:111] offset:7168
    s_mov_b32 s35, 0x42440000
    v_lshlrev_b32 v123, 16, v123
    s_cmp_ge_u32 s33, 6
    s_waitcnt lgkmcnt(0)
    s_cbranch_execz L_sk_19
    s_barrier
L_sk_19:
    s_cbranch_scc1 L_exit
    ds_read2st64_b32 v[16:17], v122 offset0:28 offset1:32
    ds_read2st64_b32 v[18:19], v122 offset0:36 offset1:40
    ds_read2st64_b32 v[20:21], v122 offset0:44 offset1:48
    ds_read2st64_b32 v[22:23], v122 offset0:52 offset1:56
    s_waitcnt lgkmcnt(2)
    v_pk_add_f32 v[16:17], v[16:17], v[18:19]
    s_waitcnt lgkmcnt(0)
    v_pk_add_f32 v[20:21], v[20:21], v[22:23]
    v_pk_add_f32 v[16:17], v[16:17], v[20:21]
    v_add_f32 v16, v16, v17
    v_cndmask_b32 v16, v16, 1.0, s[44:45]
    s_cbranch_execz L_sk_20
    s_mov_b64 exec, s[48:49]
    global_atomic_add_f32 v17, v120, v16, s[26:27] sc0 sc1
    s_mov_b64 exec, -1
    v_add_f32 v19, v16, v123
    s_waitcnt vmcnt(0)
L_sk_20:
    v_mov_b32 v18, v17 quad_perm:[3,3,3,3]
    v_add_f32 v16, v19, v17
    v_cmp_eq_f32 vcc, s35, v18
    v_cvt_pk_bf16_f32 v16, v16, v16
    s_and_b64 exec, vcc, s[46:47]
    s_cbranch_execz L_exit
    global_store_short v121, v16, s[22:23]
    s_or_b32 s34, s33, s31
    s_cmp_lg_u32 s34, 0
    s_cbranch_scc1 L_exit
    s_and_b64 exec, exec, 1
    s_cbranch_execz L_exit
    v_mov_b32 v2, s30
    global_store_dword v7, v2, s[26:27]
L_exit:
L_end:
    s_endpgm
.section .rodata,"a"
.p2align 6
.amdhsa_kernel parallel_sum__sliding_block_cached__geglu_ffn__decode_kernel
  .amdhsa_next_free_vgpr 136
  .amdhsa_next_free_sgpr 64
  .amdhsa_accum_offset 136
  .amdhsa_group_segment_fixed_size 0
  .amdhsa_kernarg_size 96
  .amdhsa_user_sgpr_count 2
  .amdhsa_user_sgpr_kernarg_segment_ptr 1
  .amdhsa_system_sgpr_workgroup_id_x 1
  .amdhsa_float_denorm_mode_32 3
.end_amdhsa_kernel
```
